```python
import torch

def _softmax(x, axis=-1):
    return torch.softmax(x, dim=axis)
def _gelu(x):
    return torch.nn.functional.gelu(x, approximate="tanh")
def _silu(x):
    return torch.nn.functional.silu(x)
def _sigmoid(x):
    return torch.sigmoid(x)
def _layernorm(x, axis=-1, eps=1e-5):
    m = x.mean(dim=axis, keepdim=True)
    v = x.var(dim=axis, keepdim=True, unbiased=False)
    return (x - m) / torch.sqrt(v + eps)
def _scatter_add(tgt, idx, src, axis=0):
    return tgt.clone().index_add_(axis, idx, src)
def _segment_sum(src, seg, n):
    out = torch.zeros((n,) + src.shape[1:], dtype=src.dtype)
    return out.index_add_(0, seg, src)
def _pad(x, pw):
    flat = tuple(v for pair in reversed(pw) for v in pair)
    return torch.nn.functional.pad(x, flat)

kernel_name = 'recurrent_scan__sliding_block_cached__dense_activation_gelu__decode'

def setup_inputs():

    _w = (lambda a: (lambda t: t.to(torch.bfloat16) if t.is_floating_point() else t)(torch.as_tensor(a)))
    def _A_setup():
        B, Sq, D = 1, 1, 512
        Hq, Hkv, Sk, Dh = 32, 8, 32768, 128
        assert Hq % Hkv == 0, (Hq, Hkv)
        return {
            "x": _w((lambda *s: torch.randn(*s, dtype=torch.bfloat16) * 0.4)(B, Sq, D)),
            "k_cache": _w((lambda *s: torch.randn(*s, dtype=torch.bfloat16) * 1.6)(B, Hkv, Sk, Dh)),
            "v_cache": _w((lambda *s: torch.randn(*s, dtype=torch.bfloat16) * 1.6)(B, Hkv, Sk, Dh)),
            "wq": _w((lambda *s: torch.randn(*s, dtype=torch.bfloat16) * 1.6)(D, Hq * Dh) * (D ** -0.5)),
            "wo": _w((lambda *s: torch.randn(*s, dtype=torch.bfloat16) * 1.6)(Hq * Dh, D) * ((Hq * Dh) ** -0.5)),
        }
    _A_in = _A_setup()

    def _B_setup():
        B, S, D, F = 1, 1, 512, 1792
        return {
            "x": _w((lambda *s: torch.randn(*s, dtype=torch.bfloat16) * 0.4)(B, S, D)),
            "w1": _w((lambda *s: torch.randn(*s, dtype=torch.bfloat16) * 1.6)(D, F) * (D ** -0.5)),
            "b1": _w((lambda *s: torch.randn(*s, dtype=torch.bfloat16) * 1.6)(F) * 0.01),
            "w2": _w((lambda *s: torch.randn(*s, dtype=torch.bfloat16) * 1.6)(F, D) * (F ** -0.5)),
            "b2": _w((lambda *s: torch.randn(*s, dtype=torch.bfloat16) * 1.6)(D) * 0.01),
        }
    _B_in = _B_setup()

    return {
        "A_x": _A_in["x"],
        "A_k_cache": _A_in["k_cache"],
        "A_v_cache": _A_in["v_cache"],
        "A_wq": _A_in["wq"],
        "A_wo": _A_in["wo"],
        "B_x": _B_in["x"],
        "B_w1": _B_in["w1"],
        "B_b1": _B_in["b1"],
        "B_w2": _B_in["w2"],
        "B_b2": _B_in["b2"],
    }

def reference(A_x, A_k_cache, A_v_cache, A_wq, A_wo, B_x, B_w1, B_b1, B_w2, B_b2):
    def _A_ref(x, k_cache, v_cache, wq, wo):
        B, Sq, D = x.shape
        Hq, Dh = 32, 128
        Hkv, Sk = k_cache.shape[1], k_cache.shape[2]
        W = min(4096, max(256, Sk // 4))
        rep = Hq // Hkv
        q = (lambda x, *d: x.permute(*d))((x @ wq).reshape(B, Sq, Hq, Dh), 0, 2, 1, 3)
        k = (lambda x, n, axis: torch.repeat_interleave(x, n, dim=axis))(k_cache[:, :, Sk - W:, :], rep, axis=1)
        v = (lambda x, n, axis: torch.repeat_interleave(x, n, dim=axis))(v_cache[:, :, Sk - W:, :], rep, axis=1)
        scores = torch.einsum("bhqd,bhkd->bhqk", q, k) * (Dh ** -0.5)
        p = _softmax(scores, axis=-1)
        o = torch.einsum("bhqk,bhkd->bhqd", p, v)
        return (lambda x, *d: x.permute(*d))(o, 0, 2, 1, 3).reshape(B, Sq, Hq * Dh) @ wo

    def _B_ref(x, w1, b1, w2, b2):
        h = torch.einsum("bsd,df->bsf", x, w1) + b1
        h = _gelu(h)
        return torch.einsum("bsf,fd->bsd", h, w2) + b2

    x = A_x
    xn = _layernorm(x, axis=-1)
    s = _A_ref(xn, A_k_cache, A_v_cache, A_wq, A_wo)
    g = _silu(_B_ref(xn, B_w1, B_b1, B_w2, B_b2))
    return x + s * g
```

```asm
; @launch grid=(256,1,1) block=(512,1,1) lds=53248
.amdgcn_target "amdgcn-amd-amdhsa--gfx950"
.text
.globl recurrent_scan__sliding_block_cached__dense_activation_gelu__decode_kernel
.p2align 8
.type recurrent_scan__sliding_block_cached__dense_activation_gelu__decode_kernel,@function
recurrent_scan__sliding_block_cached__dense_activation_gelu__decode_kernel:
    s_cmp_ge_u32 s2, 256
    s_cbranch_scc1 L_end
    s_load_dwordx16 s[16:31], s[0:1], 0
    s_load_dwordx4 s[8:11], s[0:1], 64
    s_load_dwordx2 s[12:13], s[0:1], 80
    s_load_dwordx2 s[14:15], s[0:1], 96
    v_and_b32 v1, 63, v0
    v_lshrrev_b32 v8, 6, v0
    v_and_b32 v2, 15, v0
    v_bfe_u32 v3, v0, 4, 2
    v_readfirstlane_b32 s5, v8
    s_lshr_b32 s4, s2, 3
    v_lshlrev_b32 v14, 4, v1
    s_getpc_b64 s[54:55]
    s_and_b32 s56, s4, 7
    s_cmp_lg_u32 s56, s5
    s_cbranch_scc1 L_nopf
    s_lshl_b32 s56, s56, 10
    s_add_u32 s54, s54, s56
    s_addc_u32 s55, s55, 0
    global_load_dwordx4 v[160:163], v14, s[54:55]
L_nopf:
    s_and_b32 s3, s2, 7
    v_bfe_u32 v8, v1, 1, 3
    v_and_b32 v9, 1, v1
    v_lshlrev_b32 v9, 4, v9
    v_lshl_add_u32 v9, v3, 5, v9
    v_lshl_add_u32 v10, v8, 13, v9
    v_xor_b32 v11, 0x8000, v10
    v_add_u32 v11, 0x10000, v11
    s_lshl_b32 s96, s3, 5
    s_add_u32 s96, s96, s4
    s_lshr_b32 s32, s96, 2
    s_lshl_b32 s32, s32, 7
    s_and_b32 s97, s4, 3
    s_lshl_b32 s33, s97, 3
    s_add_u32 s33, s33, s5
    s_lshl_b32 s33, s33, 17
    s_add_u32 s32, s32, s33
    s_lshl_b32 s39, s5, 11
    s_mov_b32 m0, s39
    s_add_u32 s39, s39, 1024
    v_mul_u32_u24 v124, 3584, v8
    v_add_u32 v124, v124, v9
    v_xor_b32 v125, 4, v8
    v_mul_u32_u24 v125, 3584, v125
    v_add_u32 v125, v125, v9
    s_and_b32 s36, s5, 3
    s_lshr_b32 s35, s96, 3
    s_lshl_b32 s35, s35, 7
    s_and_b32 s34, s96, 7
    s_lshl_b32 s34, s34, 2
    s_add_u32 s34, s34, s36
    s_mul_i32 s34, s34, 57344
    s_add_u32 s34, s34, s35
    s_lshl_b32 s40, s36, 11
    s_add_u32 s40, s40, 16384
    v_lshlrev_b32 v13, 7, v2
    v_and_b32 v13, 0x700, v13
    v_and_b32 v12, 1, v2
    v_lshl_add_u32 v13, v12, 6, v13
    v_lshl_add_u32 v13, v3, 4, v13
    s_lshl_b32 s37, s3, 6
    s_add_u32 s37, s37, s5
    s_lshl_b32 s37, s37, 5
    s_add_u32 s37, s37, s4
    s_lshl_b32 s37, s37, 12
    s_add_u32 s37, s37, 0x700000
    s_cmp_lg_u32 s5, 0
    s_waitcnt lgkmcnt(0)
    s_cbranch_scc1 L_nox
    global_load_dwordx4 v[108:111], v14, s[16:17]
L_nox:
    s_add_u32 s22, s22, s32
    s_addc_u32 s23, s23, 0
    global_load_lds_dwordx4 v10, s[22:23] nt
    s_mov_b32 m0, s39
    s_add_u32 s18, s18, s37
    s_addc_u32 s19, s19, 0
    global_load_lds_dwordx4 v11, s[22:23] nt
    s_load_dword s6, s[14:15], 0
    s_barrier
    global_load_dwordx4 v[16:19], v13, s[18:19] offset:0 nt
    global_load_dwordx4 v[20:23], v13, s[18:19] offset:128 nt
    s_cmp_lt_u32 s5, 4
    s_cbranch_scc1 L_now1
    s_cmp_ge_u32 s96, 224
    s_cbranch_scc1 L_now1
    s_mov_b32 m0, s40
    s_add_u32 s28, s28, s34
    s_addc_u32 s29, s29, 0
    global_load_lds_dwordx4 v124, s[28:29] nt
    s_add_u32 s40, s40, 1024
    s_mov_b32 m0, s40
    s_add_u32 s28, s28, 28672
    s_addc_u32 s29, s29, 0
    global_load_lds_dwordx4 v125, s[28:29] nt
L_now1:
    s_cmp_lg_u32 s5, 0
    s_cbranch_scc1 L_noln
    v_mov_b32 v8, 0
    v_mov_b32 v112, 0xff800000
    v_mov_b32 v113, 0xff800000
    v_mov_b32 v114, 0xff800000
    v_mov_b32 v115, 0xff800000
    v_mov_b32 v116, 0
    v_mov_b32 v117, 0
    v_mov_b32 v118, 0
    v_mov_b32 v119, 0
    s_mov_b64 exec, 1
    ds_write_b128 v8, v[112:115] offset:26624
    ds_write_b128 v8, v[116:119] offset:26640
    ds_write_b64 v8, v[116:117] offset:26656
    s_mov_b64 exec, -1
    s_waitcnt vmcnt(4)
    v_lshlrev_b32 v32, 16, v108
    v_and_b32 v33, 0xffff0000, v108
    v_lshlrev_b32 v34, 16, v109
    v_and_b32 v35, 0xffff0000, v109
    v_lshlrev_b32 v36, 16, v110
    v_and_b32 v37, 0xffff0000, v110
    v_lshlrev_b32 v38, 16, v111
    v_and_b32 v39, 0xffff0000, v111
    v_pk_add_f32 v[8:9], v[32:33], v[34:35]
    v_pk_add_f32 v[10:11], v[36:37], v[38:39]
    v_pk_add_f32 v[8:9], v[8:9], v[10:11]
    v_add_f32 v8, v8, v9
    s_nop 1
    v_add_f32_dpp v8, v8, v8 row_ror:8 row_mask:0xf bank_mask:0xf
    s_nop 1
    v_add_f32_dpp v8, v8, v8 row_ror:4 row_mask:0xf bank_mask:0xf
    s_nop 1
    v_add_f32_dpp v8, v8, v8 row_ror:2 row_mask:0xf bank_mask:0xf
    s_nop 1
    v_add_f32_dpp v8, v8, v8 row_ror:1 row_mask:0xf bank_mask:0xf
    v_mov_b32 v9, v8
    s_nop 1
    v_permlane16_swap_b32 v8, v9
    v_add_f32 v8, v8, v9
    v_mov_b32 v9, v8
    s_nop 1
    v_permlane32_swap_b32 v8, v9
    v_add_f32 v8, v8, v9
    v_mul_f32 v8, 0x3b000000, v8
    v_sub_f32 v40, v32, v8
    v_sub_f32 v41, v33, v8
    v_sub_f32 v42, v34, v8
    v_sub_f32 v43, v35, v8
    v_sub_f32 v44, v36, v8
    v_sub_f32 v45, v37, v8
    v_sub_f32 v46, v38, v8
    v_sub_f32 v47, v39, v8
    v_mul_f32 v10, v40, v40
    v_mul_f32 v11, v41, v41
    v_fmac_f32 v10, v42, v42
    v_fmac_f32 v11, v43, v43
    v_fmac_f32 v10, v44, v44
    v_fmac_f32 v11, v45, v45
    v_fmac_f32 v10, v46, v46
    v_fmac_f32 v11, v47, v47
    v_add_f32 v10, v10, v11
    v_cvt_pk_bf16_f32 v8, v8, v8
    v_and_b32 v8, 0xffff0000, v8
    v_add_f32_dpp v10, v10, v10 row_ror:8 row_mask:0xf bank_mask:0xf
    v_sub_f32 v40, v32, v8
    v_sub_f32 v41, v33, v8
    v_add_f32_dpp v10, v10, v10 row_ror:4 row_mask:0xf bank_mask:0xf
    v_sub_f32 v42, v34, v8
    v_sub_f32 v43, v35, v8
    v_add_f32_dpp v10, v10, v10 row_ror:2 row_mask:0xf bank_mask:0xf
    v_sub_f32 v44, v36, v8
    v_sub_f32 v45, v37, v8
    v_add_f32_dpp v10, v10, v10 row_ror:1 row_mask:0xf bank_mask:0xf
    v_sub_f32 v46, v38, v8
    v_sub_f32 v47, v39, v8
    v_mov_b32 v9, v10
    v_cvt_pk_bf16_f32 v11, v40, v41
    v_lshlrev_b32 v40, 16, v11
    v_and_b32 v41, 0xffff0000, v11
    v_permlane16_swap_b32 v10, v9
    v_add_f32 v10, v10, v9
    v_mov_b32 v9, v10
    v_cvt_pk_bf16_f32 v11, v42, v43
    v_lshlrev_b32 v42, 16, v11
    v_and_b32 v43, 0xffff0000, v11
    v_permlane32_swap_b32 v10, v9
    v_add_f32 v10, v10, v9
    v_mul_f32 v10, 0x3b000000, v10
    v_cvt_pk_bf16_f32 v10, v10, v10
    v_and_b32 v10, 0xffff0000, v10
    v_add_f32 v10, 0x3727c5ac, v10
    v_cvt_pk_bf16_f32 v10, v10, v10
    v_and_b32 v10, 0xffff0000, v10
    v_sqrt_f32 v10, v10
    v_cvt_pk_bf16_f32 v11, v44, v45
    v_lshlrev_b32 v44, 16, v11
    v_and_b32 v45, 0xffff0000, v11
    v_cvt_pk_bf16_f32 v10, v10, v10
    v_and_b32 v10, 0xffff0000, v10
    v_rcp_f32 v10, v10
    v_cvt_pk_bf16_f32 v11, v46, v47
    v_lshlrev_b32 v46, 16, v11
    v_and_b32 v47, 0xffff0000, v11
    v_mul_f32 v40, v40, v10
    v_mul_f32 v41, v41, v10
    v_mul_f32 v42, v42, v10
    v_mul_f32 v43, v43, v10
    v_mul_f32 v44, v44, v10
    v_mul_f32 v45, v45, v10
    v_mul_f32 v46, v46, v10
    v_mul_f32 v47, v47, v10
    v_cvt_pk_bf16_f32 v108, v40, v41
    v_cvt_pk_bf16_f32 v109, v42, v43
    v_cvt_pk_bf16_f32 v110, v44, v45
    v_cvt_pk_bf16_f32 v111, v46, v47
    ds_write_b128 v14, v[108:111] offset:24576
L_noln:
    s_add_u32 s20, s20, s37
    s_addc_u32 s21, s21, 0
    s_getreg_b32 s86, hwreg(HW_REG_XCC_ID, 0, 4)
    s_lshl_b32 s86, s86, 1
    v_lshlrev_b32 v15, 9, v3
    v_lshl_add_u32 v15, v2, 4, v15
    v_cmp_eq_u32 vcc, 1, v12
    v_mov_b32 v9, 0xffff
    v_mov_b32 v10, 0xffff0000
    v_cndmask_b32 v9, v9, v10, vcc
    s_mov_b64 s[92:93], vcc
    v_bfe_u32 v8, v2, 1, 2
    v_cmp_eq_u32 vcc, 0, v8
    s_nop 1
    v_cndmask_b32 v4, 0, v9, vcc
    v_cmp_eq_u32 vcc, 1, v8
    s_nop 1
    v_cndmask_b32 v5, 0, v9, vcc
    v_cmp_eq_u32 vcc, 2, v8
    s_nop 1
    v_cndmask_b32 v6, 0, v9, vcc
    v_cmp_eq_u32 vcc, 3, v8
    s_nop 1
    v_cndmask_b32 v7, 0, v9, vcc
    v_or_b32 v126, v4, v6
    v_or_b32 v127, v5, v7
    s_mov_b64 s[44:45], s[14:15]
    s_mov_b64 s[46:47], s[14:15]
    s_mov_b64 s[62:63], s[14:15]
    s_mov_b64 s[64:65], s[14:15]
    s_mov_b64 s[66:67], s[14:15]
    s_mov_b64 s[68:69], s[14:15]
    v_mov_b32 v99, 0
    v_mov_b32 v100, 0
    v_mov_b32 v101, 0
    v_mov_b32 v102, 0
    v_mov_b32 v103, 0
    v_mov_b32 v104, 0
    v_mov_b32 v105, 0
    v_mov_b32 v60, 0
    v_mov_b32 v61, 0
    v_mov_b32 v62, 0
    v_mov_b32 v63, 0
    s_mov_b32 s88, 0x07060503
    s_mov_b32 s89, 0x07060502
    s_mov_b32 s90, 0x07060501
    s_mov_b32 s80, 0x3db504f3
    s_mov_b32 s81, 0x3fb8aa3b
    s_mov_b32 s82, 0x11111111
    s_mov_b32 s83, 0x11111111
    v_lshrrev_b32 v8, 2, v2
    v_lshlrev_b32 v97, 2, v8
    s_lshl_b32 s32, s5, 2
    v_lshl_add_u32 v106, v8, 5, s32
    v_lshlrev_b32 v8, 8, v8
    v_lshl_add_u32 v8, v3, 4, v8
    v_lshl_add_u32 v96, v12, 6, v8
    s_mul_i32 s32, s5, 3072
    v_mul_u32_u24 v98, 768, v3
    v_lshl_add_u32 v98, v2, 4, v98
    v_add_u32 v98, s32, v98
    s_lshl_b32 s32, s36, 8
    v_lshlrev_b32 v8, 10, v3
    v_lshl_add_u32 v8, v2, 3, v8
    v_add_u32 v8, s32, v8
    v_and_b32 v9, 1, v3
    v_lshlrev_b32 v9, 7, v9
    v_add_u32 v10, v8, v9
    v_xor_b32 v9, 128, v9
    v_add_u32 v11, v8, v9
    v_lshlrev_b32 v124, 4, v3
    v_lshlrev_b32 v125, 3, v1
    s_mul_i32 s41, s3, 81920
    s_add_u32 s41, s41, 524288
    v_and_b32 v8, 3, v2
    v_lshlrev_b32 v8, 5, v8
    v_lshl_add_u32 v8, v3, 4, v8
    v_lshrrev_b32 v9, 2, v2
    s_cmp_ge_u32 s5, 4
    s_cbranch_scc1 L_B0b
    v_lshl_add_u32 v100, v9, 12, v8
    s_and_b32 s32, s4, 28
    s_add_u32 s32, s32, s5
    s_lshl_b32 s33, s97, 14
    s_lshl_b32 s34, s32, 7
    s_add_u32 s33, s33, s34
    s_add_u32 s33, s33, s41
    s_add_u32 s60, s14, s33
    s_addc_u32 s61, s15, 0
    global_load_dwordx4 v[24:27], v13, s[18:19] offset:2048 nt
    global_load_dwordx4 v[28:31], v13, s[18:19] offset:2176 nt
    s_lshl_b32 s33, s3, 5
    s_add_u32 s91, s32, s33
    s_lshl_b32 s32, s91, 14
    s_lshl_b32 s33, s97, 8
    s_add_u32 s32, s32, s33
    s_add_u32 s24, s24, s32
    s_addc_u32 s25, s25, 0
    s_lshl_b32 s32, s91, 12
    s_add_u32 s32, s32, 2097152
    s_add_u32 s62, s14, s32
    s_addc_u32 s63, s15, 0
    v_lshlrev_b32 v101, 12, v3
    v_lshl_add_u32 v101, v2, 4, v101
    v_lshrrev_b32 v8, 1, v2
    v_lshlrev_b32 v8, 7, v8
    v_lshl_add_u32 v8, v3, 5, v8
    v_lshl_add_u32 v99, v12, 4, v8
    s_lshl_b32 s32, s97, 8
    v_add_u32 v124, s32, v124
    s_lshl_b32 s32, s3, 13
    s_lshl_b32 s33, s97, 11
    s_add_u32 s33, s32, s33
    s_and_b32 s34, s4, 28
    s_add_u32 s34, s34, s5
    s_lshl_b32 s34, s34, 6
    s_add_u32 s33, s33, s34
    s_add_u32 s33, s33, 65536
    s_add_u32 s42, s14, s33
    s_addc_u32 s43, s15, 0
    s_lshl_b32 s33, s5, 9
    s_add_u32 s32, s32, s33
    s_add_u32 s32, s32, 67584
    s_add_u32 s44, s14, s32
    s_addc_u32 s45, s15, 0
    v_lshrrev_b32 v8, 5, v1
    v_and_b32 v9, 31, v1
    v_lshlrev_b32 v103, 11, v8
    v_lshl_add_u32 v103, v9, 4, v103
    s_lshl_b32 s32, s5, 8
    v_lshl_add_u32 v8, v8, 2, s32
    v_lshl_add_u32 v102, v9, 3, v8
    v_lshlrev_b32 v125, 2, v1
    s_mov_b32 s48, 0x04000c0c
    s_mov_b32 s49, 0x0706000c
    v_lshrrev_b32 v8, 3, v1
    v_lshlrev_b32 v8, 12, v8
    v_and_b32 v105, 7, v1
    v_lshl_add_u32 v105, v105, 4, v8
    s_lshl_b32 s32, s3, 17
    s_lshl_b32 s33, s5, 15
    s_add_u32 s32, s32, s33
    s_lshl_b32 s33, s4, 7
    s_add_u32 s32, s32, s33
    s_add_u32 s32, s32, 2097152
    s_add_u32 s64, s14, s32
    s_addc_u32 s65, s15, 0
    s_mul_i32 s33, s5, 768
    v_bfe_u32 v9, v1, 1, 1
    v_mul_u32_u24 v9, 384, v9
    v_lshrrev_b32 v8, 2, v1
    v_lshl_add_u32 v9, v8, 4, v9
    v_and_b32 v8, 1, v1
    v_lshl_add_u32 v9, v8, 3, v9
    v_add_u32 v104, s33, v9
    s_lshl_b32 s33, s5, 5
    v_mov_b32 v107, s33
    s_waitcnt lgkmcnt(0)
    s_lshr_b32 s6, s6, 5
    s_mul_i32 s6, s6, 0x5DEECE6D
    s_add_u32 s6, s6, 0xB
    s_lshl_b32 s6, s6, 5
    s_or_b32 s6, s6, 1
    s_or_b32 s86, s86, s6
    s_waitcnt vmcnt(4)
    s_barrier
    ds_read_b128 v[64:67], v124 offset:24576
    ds_read_b64_tr_b16 v[80:81], v10 offset:0
    ds_read_b64_tr_b16 v[82:83], v11 offset:0
    ds_read_b128 v[68:71], v124 offset:24640
    ds_read_b64_tr_b16 v[84:85], v10 offset:4096
    ds_read_b64_tr_b16 v[86:87], v11 offset:4096
    ds_read_b128 v[72:75], v124 offset:24704
    ds_read_b64_tr_b16 v[88:89], v10 offset:8192
    ds_read_b64_tr_b16 v[90:91], v11 offset:8192
    ds_read_b128 v[76:79], v124 offset:24768
    ds_read_b64_tr_b16 v[92:93], v10 offset:12288
    ds_read_b64_tr_b16 v[94:95], v11 offset:12288
    v_mov_b32 v51, s86
    s_waitcnt lgkmcnt(9)
    v_mfma_f32_16x16x32_bf16 v[56:59], v[64:67], v[80:83], 0
    s_waitcnt lgkmcnt(6)
    v_mfma_f32_16x16x32_bf16 v[56:59], v[68:71], v[84:87], v[56:59]
    s_waitcnt lgkmcnt(3)
    v_mfma_f32_16x16x32_bf16 v[56:59], v[72:75], v[88:91], v[56:59]
    s_waitcnt lgkmcnt(0)
    v_mfma_f32_16x16x32_bf16 v[56:59], v[76:79], v[92:95], v[56:59]
    s_nop 7
    v_mov_b32_dpp v52, v56 quad_perm:[0,0,0,0] row_mask:0xf bank_mask:0xf
    v_mov_b32_dpp v53, v56 quad_perm:[1,1,1,1] row_mask:0xf bank_mask:0xf
    v_mov_b32_dpp v54, v56 quad_perm:[2,2,2,2] row_mask:0xf bank_mask:0xf
    v_mov_b32_dpp v55, v56 quad_perm:[3,3,3,3] row_mask:0xf bank_mask:0xf
    v_perm_b32 v48, v52, v55, s88
    v_perm_b32 v49, v53, v55, s89
    v_perm_b32 v50, v54, v55, s90
    s_mov_b64 exec, 0x1111
    global_store_dwordx4 v125, v[48:51], s[42:43] sc1
    s_mov_b64 exec, -1
    s_barrier
    global_load_dwordx4 v[32:35], v15, s[20:21] offset:0 nt
    global_load_dwordx4 v[36:39], v15, s[20:21] offset:256 nt
    global_load_dwordx4 v[40:43], v15, s[20:21] offset:2048 nt
    s_barrier
    global_load_dwordx4 v[44:47], v15, s[20:21] offset:2304 nt
    s_waitcnt vmcnt(2)
    s_barrier
    global_load_dwordx4 v[64:67], v103, s[44:45] offset:-2048 sc1
    global_load_dwordx4 v[68:71], v103, s[44:45] offset:2048 sc1
    s_barrier
    global_load_dwordx4 v[108:111], v101, s[24:25] offset:0 nt
    global_load_dwordx4 v[112:115], v101, s[24:25] offset:1024 nt
    global_load_dwordx4 v[116:119], v101, s[24:25] offset:2048 nt
    global_load_dwordx4 v[120:123], v101, s[24:25] offset:3072 nt
    s_mov_b32 s100, 262144
    s_mov_b32 s87, 1
    s_waitcnt vmcnt(4)
    s_branch L_qchk
L_qpoll:
    global_load_dwordx4 v[64:67], v103, s[44:45] offset:-2048 sc1
    global_load_dwordx4 v[68:71], v103, s[44:45] offset:2048 sc1
    s_waitcnt vmcnt(0)
L_qchk:
    v_xor_b32 v12, s86, v67
    v_xor_b32 v13, s86, v71
    v_perm_b32 v67, v64, v65, s48
    v_perm_b32 v71, v68, v69, s48
    v_pk_add_f32 v[8:9], v[64:65], v[68:69]
    v_perm_b32 v67, v67, v66, s49
    v_perm_b32 v71, v71, v70, s49
    v_or_b32 v12, v12, v13
    v_pk_add_f32 v[10:11], v[66:67], v[70:71]
    v_and_b32 v13, 0xffffffe1, v12
    v_cmp_ne_u32 vcc, 0, v13
    v_permlane32_swap_b32 v8, v10
    v_permlane32_swap_b32 v9, v11
    v_pk_add_f32 v[8:9], v[8:9], v[10:11]
    s_sub_u32 s100, s100, 1
    v_cvt_pk_bf16_f32 v8, v8, v9
    ds_write_b32 v102, v8 offset:25600
    s_cbranch_scc1 L_qgot
    s_cbranch_vccnz L_qpoll
L_qgot:
    v_cmp_ne_u32 vcc, 0, v12
    s_nop 0
    s_cbranch_vccz L_B1
    v_mov_b32 v13, 1
    ds_write_b32 v60, v13 offset:26656
    s_branch L_B1
L_B0b:
    s_mov_b64 s[60:61], s[14:15]
    v_lshl_add_u32 v102, v9, 10, v8
    s_lshl_b32 s32, s97, 12
    s_lshr_b32 s33, s4, 2
    s_lshl_b32 s33, s33, 7
    s_add_u32 s32, s32, s33
    s_add_u32 s32, s32, s41
    s_add_u32 s32, s32, 0x10000
    s_add_u32 s62, s14, s32
    s_addc_u32 s63, s15, 0
    global_load_dwordx4 v[24:27], v13, s[18:19] offset:2048 nt
    global_load_dwordx4 v[28:31], v13, s[18:19] offset:2176 nt
    s_and_b32 s33, s96, 7
    s_lshl_b32 s32, s33, 7
    v_add_u32 v124, s32, v124
    s_mul_i32 s32, s33, 16512
    s_lshr_b32 s33, s96, 3
    s_lshl_b32 s33, s33, 9
    s_add_u32 s32, s32, s33
    s_lshl_b32 s33, s36, 7
    s_add_u32 s32, s32, s33
    s_add_u32 s32, s32, 262144
    s_add_u32 s42, s14, s32
    s_addc_u32 s43, s15, 0
    s_lshr_b32 s7, s96, 2
    s_mul_i32 s7, s7, 28
    s_lshl_b32 s32, s7, 3
    s_add_u32 s32, s32, 262144
    s_add_u32 s44, s14, s32
    s_addc_u32 s45, s15, 0
    s_lshl_b32 s32, s7, 10
    s_lshl_b32 s33, s97, 8
    s_add_u32 s32, s32, s33
    s_add_u32 s8, s8, s32
    s_addc_u32 s9, s9, 0
    s_lshl_b32 s32, s7, 1
    s_add_u32 s30, s30, s32
    s_addc_u32 s31, s31, 0
    v_and_b32 v108, 7, v2
    v_mul_u32_u24 v108, 16512, v108
    v_mul_u32_u24 v109, 7, v3
    v_lshrrev_b32 v111, 3, v2
    v_lshl_add_u32 v111, v111, 2, v109
    v_lshl_add_u32 v108, v111, 3, v108
    v_lshlrev_b32 v111, 1, v111
    v_min_u32 v112, 48, v111
    v_lshlrev_b32 v109, 10, v109
    v_lshl_add_u32 v109, v2, 4, v109
    v_add_u32 v110, 4096, v109
    s_and_b32 s32, s4, 15
    s_lshl_b32 s33, s32, 12
    s_add_u32 s33, s33, s41
    s_add_u32 s64, s14, s33
    s_addc_u32 s65, s15, 0
    s_lshl_b32 s33, s32, 10
    s_add_u32 s33, s33, s41
    s_add_u32 s33, s33, 0x10000
    s_add_u32 s66, s14, s33
    s_addc_u32 s67, s15, 0
    s_lshl_b32 s33, s32, 12
    s_lshl_b32 s34, s3, 7
    s_add_u32 s33, s33, s34
    s_add_u32 s33, s33, 458752
    s_add_u32 s68, s14, s33
    s_addc_u32 s69, s15, 0
    v_and_b32 v8, 1, v3
    v_lshlrev_b32 v8, 1, v8
    v_lshrrev_b32 v9, 1, v3
    v_add_u32 v8, v8, v9
    v_and_b32 v9, 1, v2
    v_lshl_add_u32 v8, v9, 2, v8
    v_bfe_u32 v9, v2, 1, 2
    v_lshlrev_b32 v9, 10, v9
    v_lshl_add_u32 v103, v8, 4, v9
    s_and_b32 s32, s4, 15
    s_lshl_b32 s33, s3, 4
    s_add_u32 s32, s32, s33
    s_lshr_b32 s33, s32, 1
    s_lshl_b32 s33, s33, 10
    s_and_b32 s34, s32, 1
    s_lshl_b32 s34, s34, 6
    s_add_u32 s33, s33, s34
    s_add_u32 s33, s33, 458752
    s_add_u32 s46, s14, s33
    s_addc_u32 s47, s15, 0
    v_lshrrev_b32 v8, 3, v1
    v_lshlrev_b32 v8, 7, v8
    v_and_b32 v9, 7, v1
    v_lshl_add_u32 v105, v9, 3, v8
    s_lshl_b32 s33, s32, 3
    s_add_u32 s16, s16, s33
    s_addc_u32 s17, s17, 0
    s_add_u32 s10, s10, s33
    s_addc_u32 s11, s11, 0
    s_add_u32 s12, s12, s33
    s_addc_u32 s13, s13, 0
    v_and_b32 v104, 6, v1
    s_waitcnt lgkmcnt(0)
    s_lshr_b32 s6, s6, 5
    s_mul_i32 s6, s6, 0x5DEECE6D
    s_add_u32 s6, s6, 0xB
    s_lshl_b32 s6, s6, 5
    s_or_b32 s6, s6, 1
    s_or_b32 s86, s86, s6
    s_cmp_lt_u32 s96, 224
    s_cbranch_scc1 L_bw1
    s_waitcnt vmcnt(4)
L_bw1:
    s_waitcnt vmcnt(6)
    s_barrier
    s_barrier
    global_load_dwordx4 v[32:35], v15, s[20:21] offset:0 nt
    global_load_dwordx4 v[36:39], v15, s[20:21] offset:256 nt
    global_load_dwordx4 v[40:43], v15, s[20:21] offset:2048 nt
    s_waitcnt vmcnt(5)
    s_barrier
    ds_read_b128 v[64:67], v124 offset:24576
    ds_read_b64_tr_b16 v[80:81], v10 offset:16384
    ds_read_b64_tr_b16 v[82:83], v11 offset:16384
    ds_read_b128 v[68:71], v124 offset:24640
    ds_read_b64_tr_b16 v[84:85], v10 offset:20480
    ds_read_b64_tr_b16 v[86:87], v11 offset:20480
    v_mov_b32 v49, s6
    v_mov_b32 v51, s6
    s_waitcnt lgkmcnt(3)
    v_mfma_f32_16x16x32_bf16 v[56:59], v[64:67], v[80:83], 0
    s_waitcnt lgkmcnt(0)
    v_mfma_f32_16x16x32_bf16 v[56:59], v[68:71], v[84:87], v[56:59]
    s_nop 7
    v_mov_b32 v48, v56
    v_mov_b32_dpp v50, v56 quad_perm:[1,0,3,2] row_mask:0xf bank_mask:0xf
    s_mov_b64 exec, 0x5555
    global_store_dwordx4 v125, v[48:51], s[42:43] sc1
    s_mov_b64 exec, -1
    global_load_dwordx4 v[44:47], v15, s[20:21] offset:2304 nt
    s_barrier
    s_barrier
    s_mov_b32 s87, 0
    s_cmp_lg_u32 s5, 4
    s_cbranch_scc1 L_now2
    global_load_dwordx4 v[128:131], v109, s[8:9] offset:0 nt
    global_load_dwordx4 v[132:135], v109, s[8:9] offset:1024 nt
    global_load_dwordx4 v[136:139], v109, s[8:9] offset:2048 nt
    global_load_dwordx4 v[140:143], v109, s[8:9] offset:3072 nt
    global_load_dwordx4 v[144:147], v110, s[8:9] offset:0 nt
    global_load_dwordx4 v[148:151], v110, s[8:9] offset:1024 nt
    global_load_dwordx4 v[152:155], v110, s[8:9] offset:2048 nt
    global_load_ushort v164, v111, s[30:31] offset:0
    global_load_ushort v165, v111, s[30:31] offset:2
    global_load_ushort v166, v111, s[30:31] offset:4
    global_load_ushort v167, v112, s[30:31] offset:6
    s_mov_b32 s87, 2
    s_waitcnt vmcnt(11)
    s_branch L_B1
L_now2:
    s_cmp_lg_u32 s5, 5
    s_cbranch_scc1 L_nof
    s_lshr_b32 s32, s4, 3
    s_cmp_lt_u32 s32, 2
    s_cselect_b32 s87, 3, 0
    s_cbranch_scc1 L_nof
    global_load_ushort v128, v104, s[16:17]
    global_load_ushort v129, v104, s[10:11]
    global_atomic_add_x2 v[132:133], v105, v[60:61], s[46:47] sc0 sc1
    s_waitcnt vmcnt(3)
    s_branch L_B1
L_nof:
    s_waitcnt vmcnt(0)
L_B1:
    s_waitcnt lgkmcnt(0)
    s_barrier
    ds_read_b128 v[48:51], v96 offset:25600
    ds_read_b128 v[52:55], v96 offset:25728
    ds_read_b32 v11, v60 offset:26656
    s_waitcnt lgkmcnt(2)
    v_mfma_f32_16x16x32_bf16 v[64:67], v[16:19], v[48:51], 0
    v_mfma_f32_16x16x32_bf16 v[68:71], v[24:27], v[48:51], 0
    s_waitcnt lgkmcnt(1)
    v_mfma_f32_16x16x32_bf16 v[64:67], v[20:23], v[52:55], v[64:67]
    v_mfma_f32_16x16x32_bf16 v[68:71], v[28:31], v[52:55], v[68:71]
    s_cmp_eq_u32 s87, 0
    s_cbranch_scc1 L_lated
    s_cmp_eq_u32 s87, 1
    s_cbranch_scc1 L_late1
    s_cmp_eq_u32 s87, 2
    s_cbranch_scc1 L_late2
    global_load_dwordx4 v[128:131], v14, s[64:65] offset:0 sc1
    global_load_dwordx4 v[132:135], v14, s[64:65] offset:1024 sc1
    global_load_dwordx4 v[136:139], v14, s[64:65] offset:2048 sc1
    global_load_dwordx4 v[140:143], v14, s[64:65] offset:3072 sc1
    global_load_dwordx4 v[144:147], v14, s[66:67] sc1
    s_branch L_lated
L_late2:
    global_load_dwordx4 v[156:159], v108, s[44:45] sc1
    global_load_dwordx4 v[160:163], v108, s[44:45] offset:16 sc1
    s_branch L_lated
L_late1:
    global_load_dwordx4 v[128:131], v99, s[62:63] offset:0 sc1
    global_load_dwordx4 v[132:135], v99, s[62:63] offset:1024 sc1
    global_load_dwordx4 v[136:139], v99, s[62:63] offset:2048 sc1
    global_load_dwordx4 v[140:143], v99, s[62:63] offset:3072 sc1
L_lated:
    s_waitcnt lgkmcnt(0)
    v_readfirstlane_b32 s85, v11
    s_nop 3
    s_mov_b32 s100, 262144
    v_cndmask_b32 v72, v64, v65, s[92:93]
    v_cndmask_b32 v73, v66, v67, s[92:93]
    v_cndmask_b32 v74, v68, v69, s[92:93]
    v_cndmask_b32 v75, v70, v71, s[92:93]
    v_add_f32_dpp v72, v72, v72 quad_perm:[1,0,3,2] row_mask:0xf bank_mask:0xf
    v_add_f32_dpp v73, v73, v73 quad_perm:[1,0,3,2] row_mask:0xf bank_mask:0xf
    v_add_f32_dpp v74, v74, v74 quad_perm:[1,0,3,2] row_mask:0xf bank_mask:0xf
    v_add_f32_dpp v75, v75, v75 quad_perm:[1,0,3,2] row_mask:0xf bank_mask:0xf
    v_cvt_pk_bf16_f32 v9, v72, v73
    v_cvt_pk_bf16_f32 v10, v74, v75
    v_lshlrev_b32 v72, 16, v9
    v_and_b32 v73, 0xffff0000, v9
    v_lshlrev_b32 v74, 16, v10
    v_and_b32 v75, 0xffff0000, v10
    v_mul_f32 v72, s80, v72
    v_mul_f32 v73, s80, v73
    v_mul_f32 v74, s80, v74
    v_mul_f32 v75, s80, v75
    v_cvt_pk_bf16_f32 v9, v72, v73
    v_cvt_pk_bf16_f32 v10, v74, v75
    v_lshlrev_b32 v72, 16, v9
    v_and_b32 v73, 0xffff0000, v9
    v_lshlrev_b32 v74, 16, v10
    v_and_b32 v75, 0xffff0000, v10
    v_max3_f32 v12, v72, v73, v74
    v_max_f32 v12, v12, v75
    s_mov_b64 exec, s[82:83]
    ds_max_f32 v97, v12 offset:26624
    s_mov_b64 exec, -1
    s_waitcnt lgkmcnt(0)
    s_barrier
    ds_read_b32 v12, v97 offset:26624
    s_waitcnt lgkmcnt(0)
    v_mul_f32 v11, s81, v12
    s_lshl_b32 s33, s36, 2
    v_fma_f32 v72, v72, s81, -v11
    v_fma_f32 v73, v73, s81, -v11
    v_fma_f32 v74, v74, s81, -v11
    v_fma_f32 v75, v75, s81, -v11
    v_exp_f32 v72, v72
    v_exp_f32 v73, v73
    v_exp_f32 v74, v74
    v_exp_f32 v75, v75
    v_cvt_pk_bf16_f32 v76, v72, v72
    v_cvt_pk_bf16_f32 v77, v73, v73
    v_cvt_pk_bf16_f32 v78, v74, v74
    v_cvt_pk_bf16_f32 v79, v75, v75
    v_and_b32 v80, v76, v126
    v_and_b32 v81, v76, v127
    v_and_b32 v82, v77, v126
    v_and_b32 v83, v77, v127
    v_mfma_f32_16x16x16_bf16 v[48:51], v[80:81], v[32:33], 0
    v_mfma_f32_16x16x16_bf16 v[52:55], v[80:81], v[34:35], 0
    v_add_f32 v12, v72, v73
    v_add_f32 v13, v74, v75
    v_and_b32 v84, v78, v126
    v_and_b32 v85, v78, v127
    v_mfma_f32_16x16x16_bf16 v[48:51], v[82:83], v[36:37], v[48:51]
    v_mfma_f32_16x16x16_bf16 v[52:55], v[82:83], v[38:39], v[52:55]
    v_add_f32 v10, v12, v13
    v_mov_b32 v13, v10
    v_and_b32 v86, v79, v126
    v_and_b32 v87, v79, v127
    v_mfma_f32_16x16x16_bf16 v[48:51], v[84:85], v[40:41], v[48:51]
    v_mfma_f32_16x16x16_bf16 v[52:55], v[84:85], v[42:43], v[52:55]
    v_permlane16_swap_b32 v10, v13
    v_add_f32 v10, v10, v13
    v_mov_b32 v13, v10
    v_mfma_f32_16x16x16_bf16 v[48:51], v[86:87], v[44:45], v[48:51]
    v_mfma_f32_16x16x16_bf16 v[52:55], v[86:87], v[46:47], v[52:55]
    v_permlane32_swap_b32 v10, v13
    v_add_f32 v10, v10, v13
    s_mov_b64 exec, 0x1111
    ds_write_b32 v106, v10 offset:26752
    s_mov_b64 exec, -1
    v_mov_b32 v19, s6
    v_readlane_b32 s84, v11, s33
    s_cmp_lt_u32 s5, 4
    ds_write_b128 v98, v[48:51] offset:28672
    ds_write_b128 v98, v[52:55] offset:29056
    s_waitcnt lgkmcnt(0)
    s_barrier
    s_cbranch_scc1 L_wo
    s_cmp_eq_u32 s5, 4
    s_cbranch_scc1 L_ffn2
    s_cmp_lg_u32 s5, 5
    s_cbranch_scc1 L_done
    s_branch L_tail
L_done:
    s_endpgm
L_ffn2:
    v_cmp_gt_u32 s[40:41], 8, v2
    s_waitcnt vmcnt(0)
    s_branch L_hchk
L_hpoll:
    global_load_dwordx4 v[156:159], v108, s[44:45] sc1
    global_load_dwordx4 v[160:163], v108, s[44:45] offset:16 sc1
    s_waitcnt vmcnt(0)
L_hchk:
    v_mov_b32 v14, s6
    v_cndmask_b32 v14, v14, v163, s[40:41]
    v_xor_b32 v12, s6, v157
    v_xor_b32 v13, s6, v159
    v_xor_b32 v161, s6, v161
    v_or3_b32 v12, v12, v13, v161
    v_xor_b32 v13, s6, v14
    v_or_b32 v12, v12, v13
    v_cmp_ne_u32 vcc, 0, v12
    s_sub_u32 s100, s100, 1
    s_cbranch_scc1 L_hgot
    s_cbranch_vccnz L_hpoll
L_hgot:
    v_add_f32_dpp v156, v156, v156 quad_perm:[1,0,3,2] row_mask:0xf bank_mask:0xf
    v_add_f32_dpp v158, v158, v158 quad_perm:[1,0,3,2] row_mask:0xf bank_mask:0xf
    v_add_f32_dpp v160, v160, v160 quad_perm:[1,0,3,2] row_mask:0xf bank_mask:0xf
    v_add_f32_dpp v162, v162, v162 quad_perm:[1,0,3,2] row_mask:0xf bank_mask:0xf
    v_add_f32_dpp v156, v156, v156 quad_perm:[2,3,0,1] row_mask:0xf bank_mask:0xf
    v_add_f32_dpp v158, v158, v158 quad_perm:[2,3,0,1] row_mask:0xf bank_mask:0xf
    v_add_f32_dpp v160, v160, v160 quad_perm:[2,3,0,1] row_mask:0xf bank_mask:0xf
    v_add_f32_dpp v162, v162, v162 quad_perm:[2,3,0,1] row_mask:0xf bank_mask:0xf
    v_add_f32_dpp v156, v156, v156 row_half_mirror row_mask:0xf bank_mask:0xf
    v_add_f32_dpp v158, v158, v158 row_half_mirror row_mask:0xf bank_mask:0xf
    v_add_f32_dpp v160, v160, v160 row_half_mirror row_mask:0xf bank_mask:0xf
    v_add_f32_dpp v162, v162, v162 row_half_mirror row_mask:0xf bank_mask:0xf
    v_mov_b32 v30, 0x3d372713
    v_cvt_pk_bf16_f32 v9, v156, v158
    v_lshlrev_b32 v156, 16, v9
    v_and_b32 v158, 0xffff0000, v9
    v_cvt_pk_bf16_f32 v9, v160, v162
    v_lshlrev_b32 v160, 16, v9
    v_and_b32 v162, 0xffff0000, v9
    v_lshlrev_b32 v164, 16, v164
    v_lshlrev_b32 v165, 16, v165
    v_lshlrev_b32 v166, 16, v166
    v_lshlrev_b32 v167, 16, v167
    v_add_f32 v156, v156, v164
    v_add_f32 v158, v158, v165
    v_add_f32 v160, v160, v166
    v_add_f32 v162, v162, v167
    v_cvt_pk_bf16_f32 v9, v156, v158
    v_lshlrev_b32 v156, 16, v9
    v_and_b32 v158, 0xffff0000, v9
    v_cvt_pk_bf16_f32 v9, v160, v162
    v_lshlrev_b32 v160, 16, v9
    v_and_b32 v162, 0xffff0000, v9
    v_mul_f32 v32, v156, v156
    v_mul_f32 v33, v158, v158
    v_mul_f32 v34, v160, v160
    v_mul_f32 v35, v162, v162
    v_fma_f32 v32, v32, v30, 1.0
    v_fma_f32 v33, v33, v30, 1.0
    v_fma_f32 v34, v34, v30, 1.0
    v_fma_f32 v35, v35, v30, 1.0
    v_mul_f32 v32, v32, v156
    v_mul_f32 v33, v33, v158
    v_mul_f32 v34, v34, v160
    v_mul_f32 v35, v35, v162
    v_mul_f32 v32, 0xc0135761, v32
    v_mul_f32 v33, 0xc0135761, v33
    v_mul_f32 v34, 0xc0135761, v34
    v_mul_f32 v35, 0xc0135761, v35
    v_exp_f32 v32, v32
    v_exp_f32 v33, v33
    v_exp_f32 v34, v34
    v_exp_f32 v35, v35
    v_add_f32 v32, 1.0, v32
    v_add_f32 v33, 1.0, v33
    v_add_f32 v34, 1.0, v34
    v_add_f32 v35, 1.0, v35
    v_rcp_f32 v32, v32
    v_rcp_f32 v33, v33
    v_rcp_f32 v34, v34
    v_rcp_f32 v35, v35
    v_mul_f32 v156, v156, v32
    v_mul_f32 v158, v158, v33
    v_mul_f32 v160, v160, v34
    v_mul_f32 v162, v162, v35
    v_cvt_pk_bf16_f32 v20, v156, v156
    v_cvt_pk_bf16_f32 v21, v158, v158
    v_cvt_pk_bf16_f32 v22, v160, v160
    v_cvt_pk_bf16_f32 v23, v162, v162
    v_mov_b32_dpp v24, v20 row_ror:8 row_mask:0xf bank_mask:0xf
    v_mov_b32_dpp v25, v21 row_ror:8 row_mask:0xf bank_mask:0xf
    v_mov_b32_dpp v26, v22 row_ror:8 row_mask:0xf bank_mask:0xf
    v_and_b32 v64, v20, v4
    v_and_b32 v65, v20, v5
    v_and_b32 v66, v20, v6
    v_and_b32 v67, v20, v7
    v_and_b32 v68, v21, v4
    v_and_b32 v69, v21, v5
    v_and_b32 v70, v21, v6
    v_and_b32 v71, v21, v7
    v_and_b32 v72, v22, v4
    v_and_b32 v73, v22, v5
    v_and_b32 v74, v22, v6
    v_and_b32 v75, v22, v7
    v_and_b32 v76, v23, v4
    v_and_b32 v77, v23, v5
    v_and_b32 v78, v23, v6
    v_and_b32 v79, v23, v7
    v_and_b32 v80, v24, v4
    v_and_b32 v81, v24, v5
    v_and_b32 v82, v24, v6
    v_and_b32 v83, v24, v7
    v_and_b32 v84, v25, v4
    v_and_b32 v85, v25, v5
    v_and_b32 v86, v25, v6
    v_and_b32 v87, v25, v7
    v_and_b32 v88, v26, v4
    v_and_b32 v89, v26, v5
    v_and_b32 v90, v26, v6
    v_and_b32 v91, v26, v7
    v_mfma_f32_16x16x32_bf16 v[56:59], v[64:67], v[128:131], 0
    v_mfma_f32_16x16x32_bf16 v[56:59], v[68:71], v[132:135], v[56:59]
    v_mfma_f32_16x16x32_bf16 v[56:59], v[72:75], v[136:139], v[56:59]
    v_mfma_f32_16x16x32_bf16 v[56:59], v[76:79], v[140:143], v[56:59]
    v_mfma_f32_16x16x32_bf16 v[56:59], v[80:83], v[144:147], v[56:59]
    v_mfma_f32_16x16x32_bf16 v[56:59], v[84:87], v[148:151], v[56:59]
    v_mfma_f32_16x16x32_bf16 v[56:59], v[88:91], v[152:155], v[56:59]
    s_mov_b32 exec_hi, 0
    s_nop 6
    v_perm_b32 v16, v56, v59, s88
    v_perm_b32 v17, v57, v59, s89
    v_perm_b32 v18, v58, v59, s90
    s_cmp_lg_u32 s85, 0
    s_cbranch_scc1 L_yp_slow
    global_store_dwordx4 v102, v[16:19], s[62:63]
    s_branch L_yp_done
L_yp_slow:
    s_add_u32 s62, s62, 3145728
    s_addc_u32 s63, s63, 0
    global_store_dwordx4 v102, v[16:19], s[62:63] sc1
L_yp_done:
    s_endpgm
L_wo:
    s_setprio 3
    ds_read_b128 v[20:23], v107 offset:26752
    ds_read_b128 v[24:27], v107 offset:26768
    ds_read_b64 v[32:33], v104 offset:28672
    ds_read_b64 v[34:35], v104 offset:31744
    ds_read_b64 v[36:37], v104 offset:34816
    ds_read_b64 v[38:39], v104 offset:37888
    ds_read_b64 v[40:41], v104 offset:40960
    ds_read_b64 v[42:43], v104 offset:44032
    ds_read_b64 v[44:45], v104 offset:47104
    ds_read_b64 v[46:47], v104 offset:50176
    s_waitcnt lgkmcnt(8)
    v_pk_add_f32 v[20:21], v[20:21], v[22:23]
    v_pk_add_f32 v[24:25], v[24:25], v[26:27]
    v_pk_add_f32 v[20:21], v[20:21], v[24:25]
    v_add_f32 v11, v20, v21
    v_log_f32 v13, v11
    v_rcp_f32 v11, v11
    v_add_f32 v18, s84, v13
    s_waitcnt lgkmcnt(4)
    v_pk_add_f32 v[32:33], v[32:33], v[34:35]
    v_pk_add_f32 v[36:37], v[36:37], v[38:39]
    s_waitcnt lgkmcnt(0)
    v_pk_add_f32 v[40:41], v[40:41], v[42:43]
    v_pk_add_f32 v[44:45], v[44:45], v[46:47]
    v_pk_add_f32 v[32:33], v[32:33], v[36:37]
    v_pk_add_f32 v[40:41], v[40:41], v[44:45]
    v_pk_add_f32 v[32:33], v[32:33], v[40:41]
    v_mul_f32 v16, v32, v11
    v_mul_f32 v17, v33, v11
    s_cmp_lg_u32 s85, 0
    s_cbranch_scc1 L_op_slow
    global_store_dwordx4 v105, v[16:19], s[64:65]
    s_branch L_op_done
L_op_slow:
    s_add_u32 s64, s64, 3145728
    s_addc_u32 s65, s65, 0
    global_store_dwordx4 v105, v[16:19], s[64:65] sc1
L_op_done:
    s_cmp_eq_u32 s85, 0
    s_cbranch_scc1 L_opoll
    s_add_u32 s62, s62, 3145728
    s_addc_u32 s63, s63, 0
L_opoll:
    s_branch L_om_chk
L_om_re:
    s_mov_b64 exec, s[70:71]
    s_cbranch_execz L_om_s0
    global_load_dwordx4 v[128:131], v99, s[62:63] offset:0 sc1
L_om_s0:
    s_mov_b64 exec, s[72:73]
    s_cbranch_execz L_om_s1
    global_load_dwordx4 v[132:135], v99, s[62:63] offset:1024 sc1
L_om_s1:
    s_mov_b64 exec, s[74:75]
    s_cbranch_execz L_om_s2
    global_load_dwordx4 v[136:139], v99, s[62:63] offset:2048 sc1
L_om_s2:
    s_mov_b64 exec, s[76:77]
    s_cbranch_execz L_om_s3
    global_load_dwordx4 v[140:143], v99, s[62:63] offset:3072 sc1
L_om_s3:
    s_mov_b64 exec, -1
L_om_chk:
    s_sub_u32 s100, s100, 1
    s_cbranch_scc1 L_om_out
    s_waitcnt vmcnt(0)
    v_cmp_ne_u32 s[70:71], s6, v131
    v_cmp_ne_u32 s[72:73], s6, v135
    v_cmp_ne_u32 s[74:75], s6, v139
    v_cmp_ne_u32 s[76:77], s6, v143
    s_or_b64 s[50:51], s[70:71], s[72:73]
    s_or_b64 s[50:51], s[50:51], s[74:75]
    s_or_b64 s[50:51], s[50:51], s[76:77]
    s_cbranch_scc1 L_om_re
L_om_out:
L_ogot:
    s_waitcnt vmcnt(0)
    v_max3_f32 v12, v130, v134, v138
    v_max_f32 v12, v12, v142
    s_nop 1
    v_max_f32_dpp v12, v12, v12 row_ror:8 row_mask:0xf bank_mask:0xf
    s_nop 1
    v_max_f32_dpp v12, v12, v12 row_ror:4 row_mask:0xf bank_mask:0xf
    s_nop 1
    v_max_f32_dpp v12, v12, v12 row_ror:2 row_mask:0xf bank_mask:0xf
    v_sub_f32 v130, v130, v12
    v_sub_f32 v134, v134, v12
    v_sub_f32 v138, v138, v12
    v_sub_f32 v142, v142, v12
    v_exp_f32 v130, v130
    v_exp_f32 v134, v134
    v_exp_f32 v138, v138
    v_exp_f32 v142, v142
    v_mul_f32 v12, v130, v128
    v_mul_f32 v13, v130, v129
    v_add_f32 v14, v130, v134
    v_add_f32 v9, v138, v142
    v_fmac_f32 v12, v134, v132
    v_fmac_f32 v13, v134, v133
    v_add_f32 v14, v14, v9
    v_fmac_f32 v12, v138, v136
    v_fmac_f32 v13, v138, v137
    v_fmac_f32 v12, v142, v140
    v_fmac_f32 v13, v142, v141
    v_add_f32_dpp v14, v14, v14 row_ror:8 row_mask:0xf bank_mask:0xf
    v_add_f32_dpp v12, v12, v12 row_ror:8 row_mask:0xf bank_mask:0xf
    v_add_f32_dpp v13, v13, v13 row_ror:8 row_mask:0xf bank_mask:0xf
    v_add_f32_dpp v14, v14, v14 row_ror:4 row_mask:0xf bank_mask:0xf
    v_add_f32_dpp v12, v12, v12 row_ror:4 row_mask:0xf bank_mask:0xf
    v_add_f32_dpp v13, v13, v13 row_ror:4 row_mask:0xf bank_mask:0xf
    v_add_f32_dpp v14, v14, v14 row_ror:2 row_mask:0xf bank_mask:0xf
    v_add_f32_dpp v12, v12, v12 row_ror:2 row_mask:0xf bank_mask:0xf
    v_add_f32_dpp v13, v13, v13 row_ror:2 row_mask:0xf bank_mask:0xf
    v_rcp_f32 v14, v14
    s_nop 0
    v_mul_f32 v12, v12, v14
    v_mul_f32 v13, v13, v14
    v_cvt_pk_bf16_f32 v12, v12, v12
    v_cvt_pk_bf16_f32 v13, v13, v13
    s_nop 0
    v_and_b32_dpp v80, v12, v4 quad_perm:[0,0,2,2] row_mask:0xf bank_mask:0xf
    v_and_b32_dpp v81, v12, v5 quad_perm:[0,0,2,2] row_mask:0xf bank_mask:0xf
    v_and_b32_dpp v82, v12, v6 quad_perm:[0,0,2,2] row_mask:0xf bank_mask:0xf
    v_and_b32_dpp v83, v12, v7 quad_perm:[0,0,2,2] row_mask:0xf bank_mask:0xf
    v_and_b32_dpp v84, v13, v4 quad_perm:[0,0,2,2] row_mask:0xf bank_mask:0xf
    v_and_b32_dpp v85, v13, v5 quad_perm:[0,0,2,2] row_mask:0xf bank_mask:0xf
    v_and_b32_dpp v86, v13, v6 quad_perm:[0,0,2,2] row_mask:0xf bank_mask:0xf
    v_and_b32_dpp v87, v13, v7 quad_perm:[0,0,2,2] row_mask:0xf bank_mask:0xf
    v_mfma_f32_16x16x32_bf16 v[56:59], v[80:83], v[108:111], 0
    v_and_b32_dpp v88, v12, v4 quad_perm:[1,1,3,3] row_mask:0xf bank_mask:0xf
    v_and_b32_dpp v89, v12, v5 quad_perm:[1,1,3,3] row_mask:0xf bank_mask:0xf
    v_and_b32_dpp v90, v12, v6 quad_perm:[1,1,3,3] row_mask:0xf bank_mask:0xf
    v_and_b32_dpp v91, v12, v7 quad_perm:[1,1,3,3] row_mask:0xf bank_mask:0xf
    v_mfma_f32_16x16x32_bf16 v[56:59], v[84:87], v[112:115], v[56:59]
    v_and_b32_dpp v92, v13, v4 quad_perm:[1,1,3,3] row_mask:0xf bank_mask:0xf
    v_and_b32_dpp v93, v13, v5 quad_perm:[1,1,3,3] row_mask:0xf bank_mask:0xf
    v_and_b32_dpp v94, v13, v6 quad_perm:[1,1,3,3] row_mask:0xf bank_mask:0xf
    v_and_b32_dpp v95, v13, v7 quad_perm:[1,1,3,3] row_mask:0xf bank_mask:0xf
    v_mfma_f32_16x16x32_bf16 v[56:59], v[88:91], v[116:119], v[56:59]
    s_nop 0
    v_mfma_f32_16x16x32_bf16 v[56:59], v[92:95], v[120:123], v[56:59]
    s_mov_b32 exec_hi, 0
    s_nop 6
    v_perm_b32 v16, v56, v59, s88
    v_perm_b32 v17, v57, v59, s89
    v_perm_b32 v18, v58, v59, s90
    s_cmp_lg_u32 s85, 0
    s_cbranch_scc1 L_sp_slow
    global_store_dwordx4 v100, v[16:19], s[60:61]
    s_branch L_sp_done
L_sp_slow:
    s_add_u32 s60, s60, 3145728
    s_addc_u32 s61, s61, 0
    global_store_dwordx4 v100, v[16:19], s[60:61] sc1
L_sp_done:
    s_mov_b64 exec, 1
    v_mov_b32 v8, 1
    ds_add_u32 v60, v8 offset:26660
    s_endpgm
L_tail:
    s_mov_b32 s48, 0x04000c0c
    s_mov_b32 s49, 0x0706000c
    s_cmp_eq_u32 s85, 0
    s_cbranch_scc1 L_flw
    s_add_u32 s64, s64, 3145728
    s_addc_u32 s65, s65, 0
    s_add_u32 s66, s66, 3145728
    s_addc_u32 s67, s67, 0
L_flw:
    ds_read_b32 v8, v60 offset:26660
    s_sub_u32 s100, s100, 1
    s_cbranch_scc1 L_flg
    s_waitcnt lgkmcnt(0)
    v_cmp_gt_u32 vcc, 4, v8
    s_nop 0
    s_cbranch_vccnz L_flw
L_flg:
    s_setprio 3
    s_mov_b32 s100, 262144
    s_cmp_ge_u32 s4, 16
    s_cbranch_scc1 L_final
    global_load_dwordx4 v[32:35], v14, s[64:65] offset:0 sc1
    global_load_dwordx4 v[36:39], v14, s[64:65] offset:1024 sc1
    global_load_dwordx4 v[40:43], v14, s[64:65] offset:2048 sc1
    global_load_dwordx4 v[44:47], v14, s[64:65] offset:3072 sc1
    global_load_dwordx4 v[48:51], v14, s[66:67] sc1
    s_branch L_rm_chk
L_rm_re:
    s_mov_b64 exec, s[70:71]
    s_cbranch_execz L_rm_s0
    global_load_dwordx4 v[32:35], v14, s[64:65] offset:0 sc1
L_rm_s0:
    s_mov_b64 exec, s[72:73]
    s_cbranch_execz L_rm_s1
    global_load_dwordx4 v[36:39], v14, s[64:65] offset:1024 sc1
L_rm_s1:
    s_mov_b64 exec, s[74:75]
    s_cbranch_execz L_rm_s2
    global_load_dwordx4 v[40:43], v14, s[64:65] offset:2048 sc1
L_rm_s2:
    s_mov_b64 exec, s[76:77]
    s_cbranch_execz L_rm_s3
    global_load_dwordx4 v[44:47], v14, s[64:65] offset:3072 sc1
L_rm_s3:
    s_mov_b64 exec, s[78:79]
    s_cbranch_execz L_rm_s4
    global_load_dwordx4 v[48:51], v14, s[66:67] sc1
L_rm_s4:
    s_mov_b64 exec, -1
L_rm_chk:
    s_sub_u32 s100, s100, 1
    s_cbranch_scc1 L_rm_out
    s_waitcnt vmcnt(0)
    v_cmp_ne_u32 s[70:71], s6, v35
    v_cmp_ne_u32 s[72:73], s6, v39
    v_cmp_ne_u32 s[74:75], s6, v43
    v_cmp_ne_u32 s[76:77], s6, v47
    v_cmp_ne_u32 s[78:79], s6, v51
    s_or_b64 s[50:51], s[70:71], s[72:73]
    s_or_b64 s[50:51], s[50:51], s[74:75]
    s_or_b64 s[50:51], s[50:51], s[76:77]
    s_or_b64 s[50:51], s[50:51], s[78:79]
    s_cbranch_scc1 L_rm_re
L_rm_out:
L_rgot:
    s_waitcnt vmcnt(0)
    v_perm_b32 v35, v32, v33, s48
    v_perm_b32 v39, v36, v37, s48
    v_perm_b32 v43, v40, v41, s48
    v_perm_b32 v47, v44, v45, s48
    v_perm_b32 v51, v48, v49, s48
    v_perm_b32 v35, v35, v34, s49
    v_perm_b32 v39, v39, v38, s49
    v_perm_b32 v43, v43, v42, s49
    v_perm_b32 v47, v47, v46, s49
    v_perm_b32 v51, v51, v50, s49
    v_pk_add_f32 v[32:33], v[32:33], v[36:37]
    v_pk_add_f32 v[40:41], v[40:41], v[44:45]
    v_permlane32_swap_b32 v48, v49
    v_pk_add_f32 v[34:35], v[34:35], v[38:39]
    v_pk_add_f32 v[42:43], v[42:43], v[46:47]
    v_permlane32_swap_b32 v50, v51
    v_pk_add_f32 v[32:33], v[32:33], v[40:41]
    v_pk_add_f32 v[34:35], v[34:35], v[42:43]
    v_add_f32 v48, v48, v49
    v_add_f32 v50, v50, v51
    v_permlane32_swap_b32 v32, v33
    v_permlane32_swap_b32 v34, v35
    v_permlane16_swap_b32 v48, v50
    v_add_f32 v32, v32, v33
    v_add_f32 v34, v34, v35
    v_add_f32 v48, v48, v50
    s_nop 0
    v_permlane16_swap_b32 v32, v34
    v_add_f32 v32, v32, v34
    v_add_f32_dpp v18, v48, v48 row_ror:8 row_mask:0xf bank_mask:0xf
    v_mov_b32 v17, s6
    s_mov_b32 s32, 0x00ff00ff
    s_mov_b32 s33, 0x00ff00ff
    v_add_f32_dpp v16, v32, v32 row_ror:8 row_mask:0xf bank_mask:0xf
    s_mov_b64 exec, s[32:33]
    global_store_dwordx4 v103, v[16:19], s[68:69] sc1
    s_endpgm
L_final:
    s_waitcnt vmcnt(0)
    v_lshlrev_b32 v48, 16, v128
    v_lshlrev_b32 v49, 16, v129
    global_atomic_add_x2 v[36:37], v105, v[60:61], s[46:47] sc0 sc1
    s_sleep 2
    global_atomic_add_x2 v[38:39], v105, v[60:61], s[46:47] sc0 sc1
    s_sleep 2
L_fpoll:
    global_atomic_add_x2 v[40:41], v105, v[60:61], s[46:47] sc0 sc1
    s_waitcnt vmcnt(2)
    v_mov_b32 v32, v36
    v_cmpx_ne_u32 vcc, s6, v37
    s_cbranch_execz L_fex
    global_atomic_add_x2 v[36:37], v105, v[60:61], s[46:47] sc0 sc1
    s_waitcnt vmcnt(2)
    v_mov_b32 v32, v38
    v_cmpx_ne_u32 vcc, s6, v39
    s_cbranch_execz L_fex
    global_atomic_add_x2 v[38:39], v105, v[60:61], s[46:47] sc0 sc1
    s_waitcnt vmcnt(2)
    v_mov_b32 v32, v40
    v_cmpx_ne_u32 vcc, s6, v41
    s_cbranch_execz L_fex
    s_sub_u32 s100, s100, 1
    s_cbranch_scc0 L_fpoll
L_fex:
    s_mov_b64 exec, -1
L_fgot:
    s_nop 4
    v_add_f32_dpp v32, v32, v32 row_ror:8 row_mask:0xf bank_mask:0xf
    v_mov_b32 v34, v32
    s_nop 1
    v_permlane16_swap_b32 v32, v34
    v_add_f32 v32, v32, v34
    v_mov_b32 v34, v32
    s_nop 1
    v_permlane32_swap_b32 v32, v34
    v_add_f32 v32, v32, v34
    v_cvt_pk_bf16_f32 v32, v32, v32
    v_and_b32 v32, 0xffff0000, v32
    s_nop 1
    v_mov_b32_dpp v33, v32 quad_perm:[1,1,3,3] row_mask:0xf bank_mask:0xf
    v_add_f32 v33, v33, v49
    v_cvt_pk_bf16_f32 v33, v33, v33
    v_and_b32 v33, 0xffff0000, v33
    v_mul_f32 v50, 0xbfb8aa3b, v33
    v_exp_f32 v50, v50
    s_nop 0
    v_add_f32 v50, 1.0, v50
    v_rcp_f32 v50, v50
    s_nop 0
    v_mul_f32 v50, v50, v33
    v_cvt_pk_bf16_f32 v50, v50, v50
    v_and_b32 v50, 0xffff0000, v50
    v_mul_f32 v32, v32, v50
    v_cvt_pk_bf16_f32 v32, v32, v32
    v_and_b32 v32, 0xffff0000, v32
    v_add_f32 v32, v32, v48
    v_cvt_pk_bf16_f32 v32, v32, v32
    s_mov_b64 exec, 0x55
    global_store_short v104, v32, s[12:13]
    s_cmp_lg_u32 s2, 128
    s_cbranch_scc1 L_noep
    s_mov_b64 exec, 1
    global_store_dword v60, v19, s[14:15]
L_noep:
L_end:
    s_endpgm
.fill 1024, 4, 0xbf810000
.section .rodata,"a"
.p2align 6
.amdhsa_kernel recurrent_scan__sliding_block_cached__dense_activation_gelu__decode_kernel
  .amdhsa_next_free_vgpr 168
  .amdhsa_next_free_sgpr 102
  .amdhsa_accum_offset 168
  .amdhsa_group_segment_fixed_size 0
  .amdhsa_kernarg_size 104
  .amdhsa_user_sgpr_count 2
  .amdhsa_user_sgpr_kernarg_segment_ptr 1
  .amdhsa_system_sgpr_workgroup_id_x 1
.end_amdhsa_kernel
```
